```python
import torch

def _softmax(x, axis=-1):
    return torch.softmax(x, dim=axis)
def _gelu(x):
    return torch.nn.functional.gelu(x, approximate="tanh")
def _silu(x):
    return torch.nn.functional.silu(x)
def _sigmoid(x):
    return torch.sigmoid(x)
def _layernorm(x, axis=-1, eps=1e-5):
    m = x.mean(dim=axis, keepdim=True)
    v = x.var(dim=axis, keepdim=True, unbiased=False)
    return (x - m) / torch.sqrt(v + eps)
def _scatter_add(tgt, idx, src, axis=0):
    return tgt.clone().index_add_(axis, idx, src)
def _segment_sum(src, seg, n):
    out = torch.zeros((n,) + src.shape[1:], dtype=src.dtype)
    return out.index_add_(0, seg, src)
def _pad(x, pw):
    flat = tuple(v for pair in reversed(pw) for v in pair)
    return torch.nn.functional.pad(x, flat)

kernel_name = 'standalone__gqa_softmax__decode'

def setup_inputs():

    _w = (lambda a: (lambda t: t.to(torch.bfloat16) if t.is_floating_point() else t)(torch.as_tensor(a)))
    B, Hq, Hkv, Sq, Sk, D = 4, 32, 16, 1, 4096, 128
    return {
        "q": _w((lambda *s: torch.randn(*s, dtype=torch.bfloat16) * 0.8)(B, Hq, Sq, D)),
        "k": _w((lambda *s: torch.randn(*s, dtype=torch.bfloat16) * 0.8)(B, Hkv, Sk, D)),
        "v": _w((lambda *s: torch.randn(*s, dtype=torch.bfloat16) * 0.05)(B, Hkv, Sk, D)),
    }

def reference(q, k, v):
    B, Hq, Sq, D = q.shape
    Hkv = k.shape[1]
    rep = Hq // Hkv
    k = (lambda x, n, axis: torch.repeat_interleave(x, n, dim=axis))(k, rep, axis=1)
    v = (lambda x, n, axis: torch.repeat_interleave(x, n, dim=axis))(v, rep, axis=1)
    scale = D ** -0.5
    scores = torch.einsum("bhqd,bhkd->bhqk", q, k) * scale
    p = _softmax(scores, axis=-1)
    return torch.einsum("bhqk,bhkd->bhqd", p, v)
```

```asm
; @launch grid=(256,1,1) block=(1024,1,1) lds=16656
.amdgcn_target "amdgcn-amd-amdhsa--gfx950"
.text
.globl standalone__gqa_softmax__decode_kernel
.p2align 8
.type standalone__gqa_softmax__decode_kernel,@function
standalone__gqa_softmax__decode_kernel:
  s_cmp_ge_u32 s2, 256
  s_cbranch_scc1 L_exit
  s_load_dwordx8 s[4:11], s[0:1], 0
  s_load_dwordx4 s[12:15], s[0:1], 32
  v_lshrrev_b32 v1, 6, v0
  v_and_b32 v0, 63, v0
  v_readfirstlane_b32 s3, v1
  v_lshlrev_b32 v1, 4, v0
  v_and_b32 v2, 0xf0, v1
  s_lshr_b32 s42, s2, 2
  s_lshl_b32 s43, s42, 9
  s_lshr_b32 s41, s2, 1
  s_mul_i32 s41, s41, 524288
  s_movk_i32 s44, 0x1000
  s_movk_i32 s45, 0x2000
  s_movk_i32 s46, 0x3000
  s_movk_i32 s47, 0x4000
  s_mov_b32 s19, 0x20000
  s_mov_b32 s23, 0x20000
  s_movk_i32 s26, 0x200
  s_mov_b32 s27, 0x20000
  s_cmp_lg_u32 s3, 15
  s_cbranch_scc1 L_noinit
  v_mov_b32 v3, 0
  ds_write_b32 v3, v3 offset:16644
  s_waitcnt lgkmcnt(0)
L_noinit:
  s_cmp_lt_u32 s3, 4
  s_cbranch_scc1 L_nobar
  s_barrier
L_nobar:
  s_bitcmp1_b32 s2, 0
  s_cbranch_scc1 L_odd
  s_mul_i32 s50, s3, 17408
  s_add_u32 s41, s41, s50
  s_mov_b32 s18, 17408
  s_mov_b32 s22, 17408
  s_waitcnt lgkmcnt(0)
  s_add_u32 s24, s4, s43
  s_addc_u32 s25, s5, 0
  s_add_u32 s16, s6, s41
  s_addc_u32 s17, s7, 0
  s_add_u32 s20, s8, s41
  s_addc_u32 s21, s9, 0
  buffer_load_dwordx4 v[8:11], v2, s[24:27], 0 offen
  buffer_load_dwordx4 v[12:15], v2, s[24:27], 0 offen offset:256
  buffer_load_dwordx4 v[56:59], v1, s[16:19], 0 offen nt
  buffer_load_dwordx4 v[60:63], v1, s[16:19], 0 offen offset:1024 nt
  buffer_load_dwordx4 v[64:67], v1, s[16:19], 0 offen offset:2048 nt
  buffer_load_dwordx4 v[68:71], v1, s[16:19], 0 offen offset:3072 nt
  buffer_load_dwordx4 v[72:75], v1, s[16:19], s44 offen nt
  buffer_load_dwordx4 v[76:79], v1, s[16:19], s44 offen offset:1024 nt
  buffer_load_dwordx4 v[80:83], v1, s[16:19], s44 offen offset:2048 nt
  buffer_load_dwordx4 v[84:87], v1, s[16:19], s44 offen offset:3072 nt
  buffer_load_dwordx4 v[88:91], v1, s[16:19], s45 offen nt
  buffer_load_dwordx4 v[92:95], v1, s[16:19], s45 offen offset:1024 nt
  buffer_load_dwordx4 v[96:99], v1, s[16:19], s45 offen offset:2048 nt
  buffer_load_dwordx4 v[100:103], v1, s[16:19], s45 offen offset:3072 nt
  buffer_load_dwordx4 v[104:107], v1, s[16:19], s46 offen nt
  buffer_load_dwordx4 v[108:111], v1, s[16:19], s46 offen offset:1024 nt
  buffer_load_dwordx4 v[112:115], v1, s[16:19], s46 offen offset:2048 nt
  buffer_load_dwordx4 v[116:119], v1, s[16:19], s46 offen offset:3072 nt
  buffer_load_dwordx4 v[120:123], v1, s[16:19], s47 offen nt
  buffer_load_dwordx4 v[124:127], v1, s[20:23], 0 offen nt
  s_cmp_ge_u32 s3, 4
  s_cbranch_scc1 L_nb0
  s_barrier
L_nb0:
  v_and_b32 v3, 1, v0
  v_lshlrev_b32 v3, 4, v3
  v_mov_b32 v4, 0xffff
  v_lshlrev_b32 v4, v3, v4
  v_bfe_u32 v3, v0, 1, 2
  v_cmp_eq_u32 vcc, 0, v3
  s_nop 1
  v_cndmask_b32 v38, 0, v4, vcc
  v_cmp_eq_u32 vcc, 1, v3
  s_nop 1
  v_cndmask_b32 v39, 0, v4, vcc
  v_cmp_eq_u32 vcc, 2, v3
  s_nop 1
  v_cndmask_b32 v40, 0, v4, vcc
  v_cmp_eq_u32 vcc, 3, v3
  s_nop 1
  v_cndmask_b32 v41, 0, v4, vcc
  v_and_b32 v6, 8, v0
  s_lshl_b32 s53, s3, 4
  s_add_u32 s53, s53, 16384
  v_add_u32 v6, s53, v6
  v_lshrrev_b32 v7, 5, v0
  v_lshlrev_b32 v7, 3, v7
  s_lshl_b32 s53, s3, 10
  v_add_u32 v5, s53, v1
  s_mov_b32 s48, 0x3e0293ee
  s_mov_b32 s49, 0x3f80
  v_mov_b32 v54, 0x10000
  v_mov_b32 v55, 0x1000000
  s_cmp_lt_u32 s3, 12
  s_cselect_b32 s53, 0x100, 0
  v_mov_b32 v52, 1
  v_mov_b32 v53, s53
  s_waitcnt vmcnt(17)
  v_dot2_f32_bf16 v34, v56, v8, 0
  v_dot2_f32_bf16 v35, v56, v12, 0
  v_dot2_f32_bf16 v34, v57, v9, v34
  v_dot2_f32_bf16 v35, v57, v13, v35
  v_dot2_f32_bf16 v34, v58, v10, v34
  v_dot2_f32_bf16 v35, v58, v14, v35
  v_dot2_f32_bf16 v34, v59, v11, v34
  v_dot2_f32_bf16 v35, v59, v15, v35
  buffer_load_dwordx4 v[56:59], v1, s[20:23], 0 offen offset:1024 nt
  s_waitcnt vmcnt(17)
  v_dot2_f32_bf16 v36, v60, v8, 0
  v_dot2_f32_bf16 v37, v60, v12, 0
  v_add_f32_dpp v16, v34, v34 row_ror:8 row_mask:0xf bank_mask:0x3
  v_add_f32_dpp v16, v35, v35 row_ror:8 row_mask:0xf bank_mask:0xc
  v_dot2_f32_bf16 v36, v61, v9, v36
  v_dot2_f32_bf16 v37, v61, v13, v37
  v_add_f32_dpp v16, v16, v16 row_half_mirror row_mask:0xf bank_mask:0xf
  v_dot2_f32_bf16 v36, v62, v10, v36
  v_dot2_f32_bf16 v37, v62, v14, v37
  v_add_f32_dpp v16, v16, v16 quad_perm:[1,0,3,2] row_mask:0xf bank_mask:0xf
  v_dot2_f32_bf16 v36, v63, v11, v36
  v_dot2_f32_bf16 v37, v63, v15, v37
  v_add_f32_dpp v16, v16, v16 quad_perm:[2,3,0,1] row_mask:0xf bank_mask:0xf
  buffer_load_dwordx4 v[60:63], v1, s[20:23], 0 offen offset:2048 nt
  s_waitcnt vmcnt(17)
  v_dot2_f32_bf16 v34, v64, v8, 0
  v_dot2_f32_bf16 v35, v64, v12, 0
  v_add_f32_dpp v17, v36, v36 row_ror:8 row_mask:0xf bank_mask:0x3
  v_add_f32_dpp v17, v37, v37 row_ror:8 row_mask:0xf bank_mask:0xc
  v_dot2_f32_bf16 v34, v65, v9, v34
  v_dot2_f32_bf16 v35, v65, v13, v35
  v_add_f32_dpp v17, v17, v17 row_half_mirror row_mask:0xf bank_mask:0xf
  v_dot2_f32_bf16 v34, v66, v10, v34
  v_dot2_f32_bf16 v35, v66, v14, v35
  v_add_f32_dpp v17, v17, v17 quad_perm:[1,0,3,2] row_mask:0xf bank_mask:0xf
  v_dot2_f32_bf16 v34, v67, v11, v34
  v_dot2_f32_bf16 v35, v67, v15, v35
  v_add_f32_dpp v17, v17, v17 quad_perm:[2,3,0,1] row_mask:0xf bank_mask:0xf
  buffer_load_dwordx4 v[64:67], v1, s[20:23], 0 offen offset:3072 nt
  s_waitcnt vmcnt(17)
  v_dot2_f32_bf16 v36, v68, v8, 0
  v_dot2_f32_bf16 v37, v68, v12, 0
  v_add_f32_dpp v18, v34, v34 row_ror:8 row_mask:0xf bank_mask:0x3
  v_add_f32_dpp v18, v35, v35 row_ror:8 row_mask:0xf bank_mask:0xc
  v_dot2_f32_bf16 v36, v69, v9, v36
  v_dot2_f32_bf16 v37, v69, v13, v37
  v_add_f32_dpp v18, v18, v18 row_half_mirror row_mask:0xf bank_mask:0xf
  v_dot2_f32_bf16 v36, v70, v10, v36
  v_dot2_f32_bf16 v37, v70, v14, v37
  v_add_f32_dpp v18, v18, v18 quad_perm:[1,0,3,2] row_mask:0xf bank_mask:0xf
  v_dot2_f32_bf16 v36, v71, v11, v36
  v_dot2_f32_bf16 v37, v71, v15, v37
  v_add_f32_dpp v18, v18, v18 quad_perm:[2,3,0,1] row_mask:0xf bank_mask:0xf
  buffer_load_dwordx4 v[68:71], v1, s[20:23], s44 offen nt
  s_waitcnt vmcnt(17)
  v_dot2_f32_bf16 v34, v72, v8, 0
  v_dot2_f32_bf16 v35, v72, v12, 0
  v_add_f32_dpp v19, v36, v36 row_ror:8 row_mask:0xf bank_mask:0x3
  v_add_f32_dpp v19, v37, v37 row_ror:8 row_mask:0xf bank_mask:0xc
  v_dot2_f32_bf16 v34, v73, v9, v34
  v_dot2_f32_bf16 v35, v73, v13, v35
  v_add_f32_dpp v19, v19, v19 row_half_mirror row_mask:0xf bank_mask:0xf
  v_dot2_f32_bf16 v34, v74, v10, v34
  v_dot2_f32_bf16 v35, v74, v14, v35
  v_add_f32_dpp v19, v19, v19 quad_perm:[1,0,3,2] row_mask:0xf bank_mask:0xf
  v_dot2_f32_bf16 v34, v75, v11, v34
  v_dot2_f32_bf16 v35, v75, v15, v35
  v_add_f32_dpp v19, v19, v19 quad_perm:[2,3,0,1] row_mask:0xf bank_mask:0xf
  buffer_load_dwordx4 v[72:75], v1, s[20:23], s44 offen offset:1024 nt
  s_waitcnt vmcnt(17)
  v_dot2_f32_bf16 v36, v76, v8, 0
  v_dot2_f32_bf16 v37, v76, v12, 0
  v_add_f32_dpp v20, v34, v34 row_ror:8 row_mask:0xf bank_mask:0x3
  v_add_f32_dpp v20, v35, v35 row_ror:8 row_mask:0xf bank_mask:0xc
  v_dot2_f32_bf16 v36, v77, v9, v36
  v_dot2_f32_bf16 v37, v77, v13, v37
  v_add_f32_dpp v20, v20, v20 row_half_mirror row_mask:0xf bank_mask:0xf
  v_dot2_f32_bf16 v36, v78, v10, v36
  v_dot2_f32_bf16 v37, v78, v14, v37
  v_add_f32_dpp v20, v20, v20 quad_perm:[1,0,3,2] row_mask:0xf bank_mask:0xf
  v_dot2_f32_bf16 v36, v79, v11, v36
  v_dot2_f32_bf16 v37, v79, v15, v37
  v_add_f32_dpp v20, v20, v20 quad_perm:[2,3,0,1] row_mask:0xf bank_mask:0xf
  buffer_load_dwordx4 v[76:79], v1, s[20:23], s44 offen offset:2048 nt
  s_waitcnt vmcnt(17)
  v_dot2_f32_bf16 v34, v80, v8, 0
  v_dot2_f32_bf16 v35, v80, v12, 0
  v_add_f32_dpp v21, v36, v36 row_ror:8 row_mask:0xf bank_mask:0x3
  v_add_f32_dpp v21, v37, v37 row_ror:8 row_mask:0xf bank_mask:0xc
  v_dot2_f32_bf16 v34, v81, v9, v34
  v_dot2_f32_bf16 v35, v81, v13, v35
  v_add_f32_dpp v21, v21, v21 row_half_mirror row_mask:0xf bank_mask:0xf
  v_dot2_f32_bf16 v34, v82, v10, v34
  v_dot2_f32_bf16 v35, v82, v14, v35
  v_add_f32_dpp v21, v21, v21 quad_perm:[1,0,3,2] row_mask:0xf bank_mask:0xf
  v_dot2_f32_bf16 v34, v83, v11, v34
  v_dot2_f32_bf16 v35, v83, v15, v35
  v_add_f32_dpp v21, v21, v21 quad_perm:[2,3,0,1] row_mask:0xf bank_mask:0xf
  buffer_load_dwordx4 v[80:83], v1, s[20:23], s44 offen offset:3072 nt
  s_waitcnt vmcnt(17)
  v_dot2_f32_bf16 v36, v84, v8, 0
  v_dot2_f32_bf16 v37, v84, v12, 0
  v_add_f32_dpp v22, v34, v34 row_ror:8 row_mask:0xf bank_mask:0x3
  v_add_f32_dpp v22, v35, v35 row_ror:8 row_mask:0xf bank_mask:0xc
  v_dot2_f32_bf16 v36, v85, v9, v36
  v_dot2_f32_bf16 v37, v85, v13, v37
  v_add_f32_dpp v22, v22, v22 row_half_mirror row_mask:0xf bank_mask:0xf
  v_dot2_f32_bf16 v36, v86, v10, v36
  v_dot2_f32_bf16 v37, v86, v14, v37
  v_add_f32_dpp v22, v22, v22 quad_perm:[1,0,3,2] row_mask:0xf bank_mask:0xf
  v_dot2_f32_bf16 v36, v87, v11, v36
  v_dot2_f32_bf16 v37, v87, v15, v37
  v_add_f32_dpp v22, v22, v22 quad_perm:[2,3,0,1] row_mask:0xf bank_mask:0xf
  buffer_load_dwordx4 v[84:87], v1, s[20:23], s45 offen nt
  s_waitcnt vmcnt(17)
  v_dot2_f32_bf16 v34, v88, v8, 0
  v_dot2_f32_bf16 v35, v88, v12, 0
  v_add_f32_dpp v23, v36, v36 row_ror:8 row_mask:0xf bank_mask:0x3
  v_add_f32_dpp v23, v37, v37 row_ror:8 row_mask:0xf bank_mask:0xc
  v_dot2_f32_bf16 v34, v89, v9, v34
  v_dot2_f32_bf16 v35, v89, v13, v35
  v_add_f32_dpp v23, v23, v23 row_half_mirror row_mask:0xf bank_mask:0xf
  v_dot2_f32_bf16 v34, v90, v10, v34
  v_dot2_f32_bf16 v35, v90, v14, v35
  v_add_f32_dpp v23, v23, v23 quad_perm:[1,0,3,2] row_mask:0xf bank_mask:0xf
  v_dot2_f32_bf16 v34, v91, v11, v34
  v_dot2_f32_bf16 v35, v91, v15, v35
  v_add_f32_dpp v23, v23, v23 quad_perm:[2,3,0,1] row_mask:0xf bank_mask:0xf
  buffer_load_dwordx4 v[88:91], v1, s[20:23], s45 offen offset:1024 nt
  s_waitcnt vmcnt(17)
  v_dot2_f32_bf16 v36, v92, v8, 0
  v_dot2_f32_bf16 v37, v92, v12, 0
  v_add_f32_dpp v24, v34, v34 row_ror:8 row_mask:0xf bank_mask:0x3
  v_add_f32_dpp v24, v35, v35 row_ror:8 row_mask:0xf bank_mask:0xc
  v_dot2_f32_bf16 v36, v93, v9, v36
  v_dot2_f32_bf16 v37, v93, v13, v37
  v_add_f32_dpp v24, v24, v24 row_half_mirror row_mask:0xf bank_mask:0xf
  v_dot2_f32_bf16 v36, v94, v10, v36
  v_dot2_f32_bf16 v37, v94, v14, v37
  v_add_f32_dpp v24, v24, v24 quad_perm:[1,0,3,2] row_mask:0xf bank_mask:0xf
  v_dot2_f32_bf16 v36, v95, v11, v36
  v_dot2_f32_bf16 v37, v95, v15, v37
  v_add_f32_dpp v24, v24, v24 quad_perm:[2,3,0,1] row_mask:0xf bank_mask:0xf
  buffer_load_dwordx4 v[92:95], v1, s[20:23], s45 offen offset:2048 nt
  s_waitcnt vmcnt(17)
  v_dot2_f32_bf16 v34, v96, v8, 0
  v_dot2_f32_bf16 v35, v96, v12, 0
  v_add_f32_dpp v25, v36, v36 row_ror:8 row_mask:0xf bank_mask:0x3
  v_add_f32_dpp v25, v37, v37 row_ror:8 row_mask:0xf bank_mask:0xc
  v_dot2_f32_bf16 v34, v97, v9, v34
  v_dot2_f32_bf16 v35, v97, v13, v35
  v_add_f32_dpp v25, v25, v25 row_half_mirror row_mask:0xf bank_mask:0xf
  v_dot2_f32_bf16 v34, v98, v10, v34
  v_dot2_f32_bf16 v35, v98, v14, v35
  v_add_f32_dpp v25, v25, v25 quad_perm:[1,0,3,2] row_mask:0xf bank_mask:0xf
  v_dot2_f32_bf16 v34, v99, v11, v34
  v_dot2_f32_bf16 v35, v99, v15, v35
  v_add_f32_dpp v25, v25, v25 quad_perm:[2,3,0,1] row_mask:0xf bank_mask:0xf
  buffer_load_dwordx4 v[96:99], v1, s[20:23], s45 offen offset:3072 nt
  s_waitcnt vmcnt(17)
  v_dot2_f32_bf16 v36, v100, v8, 0
  v_dot2_f32_bf16 v37, v100, v12, 0
  v_add_f32_dpp v26, v34, v34 row_ror:8 row_mask:0xf bank_mask:0x3
  v_add_f32_dpp v26, v35, v35 row_ror:8 row_mask:0xf bank_mask:0xc
  v_dot2_f32_bf16 v36, v101, v9, v36
  v_dot2_f32_bf16 v37, v101, v13, v37
  v_add_f32_dpp v26, v26, v26 row_half_mirror row_mask:0xf bank_mask:0xf
  v_dot2_f32_bf16 v36, v102, v10, v36
  v_dot2_f32_bf16 v37, v102, v14, v37
  v_add_f32_dpp v26, v26, v26 quad_perm:[1,0,3,2] row_mask:0xf bank_mask:0xf
  v_dot2_f32_bf16 v36, v103, v11, v36
  v_dot2_f32_bf16 v37, v103, v15, v37
  v_add_f32_dpp v26, v26, v26 quad_perm:[2,3,0,1] row_mask:0xf bank_mask:0xf
  buffer_load_dwordx4 v[100:103], v1, s[20:23], s46 offen nt
  s_waitcnt vmcnt(17)
  v_dot2_f32_bf16 v34, v104, v8, 0
  v_dot2_f32_bf16 v35, v104, v12, 0
  v_add_f32_dpp v27, v36, v36 row_ror:8 row_mask:0xf bank_mask:0x3
  v_add_f32_dpp v27, v37, v37 row_ror:8 row_mask:0xf bank_mask:0xc
  v_dot2_f32_bf16 v34, v105, v9, v34
  v_dot2_f32_bf16 v35, v105, v13, v35
  v_add_f32_dpp v27, v27, v27 row_half_mirror row_mask:0xf bank_mask:0xf
  v_dot2_f32_bf16 v34, v106, v10, v34
  v_dot2_f32_bf16 v35, v106, v14, v35
  v_add_f32_dpp v27, v27, v27 quad_perm:[1,0,3,2] row_mask:0xf bank_mask:0xf
  v_dot2_f32_bf16 v34, v107, v11, v34
  v_dot2_f32_bf16 v35, v107, v15, v35
  v_add_f32_dpp v27, v27, v27 quad_perm:[2,3,0,1] row_mask:0xf bank_mask:0xf
  buffer_load_dwordx4 v[104:107], v1, s[20:23], s46 offen offset:1024 nt
  s_mov_b64 exec, 1
  ds_add_u32 v1, v55 offset:16644
  s_mov_b64 exec, -1
  s_waitcnt vmcnt(17)
  v_dot2_f32_bf16 v36, v108, v8, 0
  v_dot2_f32_bf16 v37, v108, v12, 0
  v_add_f32_dpp v28, v34, v34 row_ror:8 row_mask:0xf bank_mask:0x3
  v_add_f32_dpp v28, v35, v35 row_ror:8 row_mask:0xf bank_mask:0xc
  v_dot2_f32_bf16 v36, v109, v9, v36
  v_dot2_f32_bf16 v37, v109, v13, v37
  v_add_f32_dpp v28, v28, v28 row_half_mirror row_mask:0xf bank_mask:0xf
  v_dot2_f32_bf16 v36, v110, v10, v36
  v_dot2_f32_bf16 v37, v110, v14, v37
  v_add_f32_dpp v28, v28, v28 quad_perm:[1,0,3,2] row_mask:0xf bank_mask:0xf
  v_dot2_f32_bf16 v36, v111, v11, v36
  v_dot2_f32_bf16 v37, v111, v15, v37
  v_add_f32_dpp v28, v28, v28 quad_perm:[2,3,0,1] row_mask:0xf bank_mask:0xf
  buffer_load_dwordx4 v[108:111], v1, s[20:23], s46 offen offset:2048 nt
  s_waitcnt vmcnt(17)
  v_dot2_f32_bf16 v34, v112, v8, 0
  v_dot2_f32_bf16 v35, v112, v12, 0
  v_add_f32_dpp v29, v36, v36 row_ror:8 row_mask:0xf bank_mask:0x3
  v_add_f32_dpp v29, v37, v37 row_ror:8 row_mask:0xf bank_mask:0xc
  v_dot2_f32_bf16 v34, v113, v9, v34
  v_dot2_f32_bf16 v35, v113, v13, v35
  v_add_f32_dpp v29, v29, v29 row_half_mirror row_mask:0xf bank_mask:0xf
  v_dot2_f32_bf16 v34, v114, v10, v34
  v_dot2_f32_bf16 v35, v114, v14, v35
  v_add_f32_dpp v29, v29, v29 quad_perm:[1,0,3,2] row_mask:0xf bank_mask:0xf
  v_dot2_f32_bf16 v34, v115, v11, v34
  v_dot2_f32_bf16 v35, v115, v15, v35
  v_add_f32_dpp v29, v29, v29 quad_perm:[2,3,0,1] row_mask:0xf bank_mask:0xf
  buffer_load_dwordx4 v[112:115], v1, s[20:23], s46 offen offset:3072 nt
  s_waitcnt vmcnt(17)
  v_dot2_f32_bf16 v36, v116, v8, 0
  v_dot2_f32_bf16 v37, v116, v12, 0
  v_add_f32_dpp v30, v34, v34 row_ror:8 row_mask:0xf bank_mask:0x3
  v_add_f32_dpp v30, v35, v35 row_ror:8 row_mask:0xf bank_mask:0xc
  v_dot2_f32_bf16 v36, v117, v9, v36
  v_dot2_f32_bf16 v37, v117, v13, v37
  v_add_f32_dpp v30, v30, v30 row_half_mirror row_mask:0xf bank_mask:0xf
  v_dot2_f32_bf16 v36, v118, v10, v36
  v_dot2_f32_bf16 v37, v118, v14, v37
  v_add_f32_dpp v30, v30, v30 quad_perm:[1,0,3,2] row_mask:0xf bank_mask:0xf
  v_dot2_f32_bf16 v36, v119, v11, v36
  v_dot2_f32_bf16 v37, v119, v15, v37
  v_add_f32_dpp v30, v30, v30 quad_perm:[2,3,0,1] row_mask:0xf bank_mask:0xf
  buffer_load_dwordx4 v[116:119], v1, s[20:23], s47 offen nt
  s_waitcnt vmcnt(17)
  v_dot2_f32_bf16 v34, v120, v8, 0
  v_dot2_f32_bf16 v35, v120, v12, 0
  v_add_f32_dpp v31, v36, v36 row_ror:8 row_mask:0xf bank_mask:0x3
  v_add_f32_dpp v31, v37, v37 row_ror:8 row_mask:0xf bank_mask:0xc
  v_dot2_f32_bf16 v34, v121, v9, v34
  v_dot2_f32_bf16 v35, v121, v13, v35
  v_add_f32_dpp v31, v31, v31 row_half_mirror row_mask:0xf bank_mask:0xf
  v_dot2_f32_bf16 v34, v122, v10, v34
  v_dot2_f32_bf16 v35, v122, v14, v35
  v_add_f32_dpp v31, v31, v31 quad_perm:[1,0,3,2] row_mask:0xf bank_mask:0xf
  v_dot2_f32_bf16 v34, v123, v11, v34
  v_dot2_f32_bf16 v35, v123, v15, v35
  v_add_f32_dpp v31, v31, v31 quad_perm:[2,3,0,1] row_mask:0xf bank_mask:0xf
  s_nop 2
  v_add_f32_dpp v32, v34, v34 row_ror:8 row_mask:0xf bank_mask:0x3
  v_add_f32_dpp v32, v35, v35 row_ror:8 row_mask:0xf bank_mask:0xc
  s_nop 1
  v_add_f32_dpp v32, v32, v32 row_half_mirror row_mask:0xf bank_mask:0xf
  s_nop 1
  v_add_f32_dpp v32, v32, v32 quad_perm:[1,0,3,2] row_mask:0xf bank_mask:0xf
  s_nop 1
  v_add_f32_dpp v32, v32, v32 quad_perm:[2,3,0,1] row_mask:0xf bank_mask:0xf
  s_nop 1
  v_max3_f32 v49, v16, v17, v18
  v_max3_f32 v49, v49, v19, v20
  v_max3_f32 v49, v49, v21, v22
  v_max3_f32 v49, v49, v23, v24
  v_max3_f32 v49, v49, v25, v26
  v_max3_f32 v49, v49, v27, v28
  v_max3_f32 v49, v49, v29, v30
  v_max3_f32 v49, v49, v31, v32
  v_mov_b32 v50, v49
  s_nop 1
  v_permlane16_swap_b32 v49, v50
  v_max_f32 v49, v49, v50
  v_mov_b32 v50, v49
  s_nop 1
  v_permlane32_swap_b32 v49, v50
  v_max_f32 v49, v49, v50
  v_mul_f32 v46, s48, v49
  v_fma_f32 v16, v16, s48, -v46
  v_fma_f32 v17, v17, s48, -v46
  v_fma_f32 v18, v18, s48, -v46
  v_fma_f32 v19, v19, s48, -v46
  v_fma_f32 v20, v20, s48, -v46
  v_fma_f32 v21, v21, s48, -v46
  v_fma_f32 v22, v22, s48, -v46
  v_fma_f32 v23, v23, s48, -v46
  v_fma_f32 v24, v24, s48, -v46
  v_fma_f32 v25, v25, s48, -v46
  v_fma_f32 v26, v26, s48, -v46
  v_fma_f32 v27, v27, s48, -v46
  v_fma_f32 v28, v28, s48, -v46
  v_fma_f32 v29, v29, s48, -v46
  v_fma_f32 v30, v30, s48, -v46
  v_fma_f32 v31, v31, s48, -v46
  v_fma_f32 v32, v32, s48, -v46
  v_exp_f32 v16, v16
  v_exp_f32 v17, v17
  v_exp_f32 v18, v18
  v_exp_f32 v19, v19
  v_exp_f32 v20, v20
  v_exp_f32 v21, v21
  v_exp_f32 v22, v22
  v_exp_f32 v23, v23
  v_exp_f32 v24, v24
  v_exp_f32 v25, v25
  v_exp_f32 v26, v26
  v_exp_f32 v27, v27
  v_exp_f32 v28, v28
  v_exp_f32 v29, v29
  v_exp_f32 v30, v30
  v_exp_f32 v31, v31
  v_exp_f32 v32, v32
  v_cvt_pk_bf16_f32 v16, v16, v16
  v_cvt_pk_bf16_f32 v17, v17, v17
  v_cvt_pk_bf16_f32 v18, v18, v18
  v_cvt_pk_bf16_f32 v19, v19, v19
  v_cvt_pk_bf16_f32 v20, v20, v20
  v_cvt_pk_bf16_f32 v21, v21, v21
  v_cvt_pk_bf16_f32 v22, v22, v22
  v_cvt_pk_bf16_f32 v23, v23, v23
  v_cvt_pk_bf16_f32 v24, v24, v24
  v_cvt_pk_bf16_f32 v25, v25, v25
  v_cvt_pk_bf16_f32 v26, v26, v26
  v_cvt_pk_bf16_f32 v27, v27, v27
  v_cvt_pk_bf16_f32 v28, v28, v28
  v_cvt_pk_bf16_f32 v29, v29, v29
  v_cvt_pk_bf16_f32 v30, v30, v30
  v_cvt_pk_bf16_f32 v31, v31, v31
  v_cvt_pk_bf16_f32 v32, v32, v32
  v_dot2_f32_bf16 v47, v16, s49, 0
  v_dot2_f32_bf16 v47, v17, s49, v47
  v_dot2_f32_bf16 v47, v18, s49, v47
  v_dot2_f32_bf16 v47, v19, s49, v47
  v_dot2_f32_bf16 v47, v20, s49, v47
  v_dot2_f32_bf16 v47, v21, s49, v47
  v_dot2_f32_bf16 v47, v22, s49, v47
  v_dot2_f32_bf16 v47, v23, s49, v47
  v_dot2_f32_bf16 v47, v24, s49, v47
  v_dot2_f32_bf16 v47, v25, s49, v47
  v_dot2_f32_bf16 v47, v26, s49, v47
  v_dot2_f32_bf16 v47, v27, s49, v47
  v_dot2_f32_bf16 v47, v28, s49, v47
  v_dot2_f32_bf16 v47, v29, s49, v47
  v_dot2_f32_bf16 v47, v30, s49, v47
  v_dot2_f32_bf16 v47, v31, s49, v47
  v_dot2_f32_bf16 v47, v32, s49, v47
  s_nop 2
  v_mov_b32 v50, v47
  s_nop 1
  v_permlane16_swap_b32 v47, v50
  v_add_f32 v47, v47, v50
  v_mov_b32 v50, v47
  s_nop 1
  v_permlane32_swap_b32 v47, v50
  v_add_f32 v47, v47, v50
  ds_write_b64 v6, v[46:47]
  s_mov_b64 exec, 1
  ds_add_u32 v1, v54 offset:16644
  s_mov_b64 exec, -1
  v_and_b32 v8, v16, v38
  v_and_b32 v9, v16, v39
  v_and_b32 v10, v16, v40
  v_and_b32 v11, v16, v41
  v_and_b32 v12, v17, v38
  v_and_b32 v13, v17, v39
  v_and_b32 v14, v17, v40
  v_and_b32 v15, v17, v41
  s_waitcnt vmcnt(16)
  v_mfma_f32_16x16x32_bf16 v[42:45], v[8:11], v[124:127], 0
  v_and_b32 v8, v18, v38
  v_and_b32 v9, v18, v39
  v_and_b32 v10, v18, v40
  v_and_b32 v11, v18, v41
  s_waitcnt vmcnt(15)
  v_mfma_f32_16x16x32_bf16 v[42:45], v[12:15], v[56:59], v[42:45]
  v_and_b32 v12, v19, v38
  v_and_b32 v13, v19, v39
  v_and_b32 v14, v19, v40
  v_and_b32 v15, v19, v41
  s_waitcnt vmcnt(14)
  v_mfma_f32_16x16x32_bf16 v[42:45], v[8:11], v[60:63], v[42:45]
  v_and_b32 v8, v20, v38
  v_and_b32 v9, v20, v39
  v_and_b32 v10, v20, v40
  v_and_b32 v11, v20, v41
  s_waitcnt vmcnt(13)
  v_mfma_f32_16x16x32_bf16 v[42:45], v[12:15], v[64:67], v[42:45]
  v_and_b32 v12, v21, v38
  v_and_b32 v13, v21, v39
  v_and_b32 v14, v21, v40
  v_and_b32 v15, v21, v41
  s_waitcnt vmcnt(12)
  v_mfma_f32_16x16x32_bf16 v[42:45], v[8:11], v[68:71], v[42:45]
  v_and_b32 v8, v22, v38
  v_and_b32 v9, v22, v39
  v_and_b32 v10, v22, v40
  v_and_b32 v11, v22, v41
  s_waitcnt vmcnt(11)
  v_mfma_f32_16x16x32_bf16 v[42:45], v[12:15], v[72:75], v[42:45]
  v_and_b32 v12, v23, v38
  v_and_b32 v13, v23, v39
  v_and_b32 v14, v23, v40
  v_and_b32 v15, v23, v41
  s_waitcnt vmcnt(10)
  v_mfma_f32_16x16x32_bf16 v[42:45], v[8:11], v[76:79], v[42:45]
  v_and_b32 v8, v24, v38
  v_and_b32 v9, v24, v39
  v_and_b32 v10, v24, v40
  v_and_b32 v11, v24, v41
  s_waitcnt vmcnt(9)
  v_mfma_f32_16x16x32_bf16 v[42:45], v[12:15], v[80:83], v[42:45]
  v_and_b32 v12, v25, v38
  v_and_b32 v13, v25, v39
  v_and_b32 v14, v25, v40
  v_and_b32 v15, v25, v41
  s_waitcnt vmcnt(8)
  v_mfma_f32_16x16x32_bf16 v[42:45], v[8:11], v[84:87], v[42:45]
  v_and_b32 v8, v26, v38
  v_and_b32 v9, v26, v39
  v_and_b32 v10, v26, v40
  v_and_b32 v11, v26, v41
  s_waitcnt vmcnt(7)
  v_mfma_f32_16x16x32_bf16 v[42:45], v[12:15], v[88:91], v[42:45]
  v_and_b32 v12, v27, v38
  v_and_b32 v13, v27, v39
  v_and_b32 v14, v27, v40
  v_and_b32 v15, v27, v41
  s_waitcnt vmcnt(6)
  v_mfma_f32_16x16x32_bf16 v[42:45], v[8:11], v[92:95], v[42:45]
  v_and_b32 v8, v28, v38
  v_and_b32 v9, v28, v39
  v_and_b32 v10, v28, v40
  v_and_b32 v11, v28, v41
  s_waitcnt vmcnt(5)
  s_mov_b64 exec, 1
  ds_add_u32 v1, v52 offset:16644
  s_mov_b64 exec, -1
  v_mfma_f32_16x16x32_bf16 v[42:45], v[12:15], v[96:99], v[42:45]
  v_and_b32 v12, v29, v38
  v_and_b32 v13, v29, v39
  v_and_b32 v14, v29, v40
  v_and_b32 v15, v29, v41
  s_waitcnt vmcnt(4)
  v_mfma_f32_16x16x32_bf16 v[42:45], v[8:11], v[100:103], v[42:45]
  v_and_b32 v8, v30, v38
  v_and_b32 v9, v30, v39
  v_and_b32 v10, v30, v40
  v_and_b32 v11, v30, v41
  s_waitcnt vmcnt(3)
  v_mfma_f32_16x16x32_bf16 v[42:45], v[12:15], v[104:107], v[42:45]
  v_and_b32 v12, v31, v38
  v_and_b32 v13, v31, v39
  v_and_b32 v14, v31, v40
  v_and_b32 v15, v31, v41
  s_waitcnt vmcnt(2)
  v_mfma_f32_16x16x32_bf16 v[42:45], v[8:11], v[108:111], v[42:45]
  v_and_b32 v8, v32, v38
  v_and_b32 v9, v32, v39
  v_and_b32 v10, v32, v40
  v_and_b32 v11, v32, v41
  s_waitcnt vmcnt(1)
  v_mfma_f32_16x16x32_bf16 v[42:45], v[12:15], v[112:115], v[42:45]
  s_nop 1
  s_waitcnt vmcnt(0)
  v_mfma_f32_16x16x32_bf16 v[42:45], v[8:11], v[116:119], v[42:45]
  s_branch L_join
L_odd:
  s_mul_i32 s50, s3, 15360
  s_add_u32 s41, s41, s50
  s_add_u32 s41, s41, 278528
  s_mov_b32 s18, 15360
  s_mov_b32 s22, 15360
  s_waitcnt lgkmcnt(0)
  s_add_u32 s24, s4, s43
  s_addc_u32 s25, s5, 0
  s_add_u32 s16, s6, s41
  s_addc_u32 s17, s7, 0
  s_add_u32 s20, s8, s41
  s_addc_u32 s21, s9, 0
  buffer_load_dwordx4 v[8:11], v2, s[24:27], 0 offen
  buffer_load_dwordx4 v[12:15], v2, s[24:27], 0 offen offset:256
  buffer_load_dwordx4 v[56:59], v1, s[16:19], 0 offen nt
  buffer_load_dwordx4 v[60:63], v1, s[16:19], 0 offen offset:1024 nt
  buffer_load_dwordx4 v[64:67], v1, s[16:19], 0 offen offset:2048 nt
  buffer_load_dwordx4 v[68:71], v1, s[16:19], 0 offen offset:3072 nt
  buffer_load_dwordx4 v[72:75], v1, s[16:19], s44 offen nt
  buffer_load_dwordx4 v[76:79], v1, s[16:19], s44 offen offset:1024 nt
  buffer_load_dwordx4 v[80:83], v1, s[16:19], s44 offen offset:2048 nt
  buffer_load_dwordx4 v[84:87], v1, s[16:19], s44 offen offset:3072 nt
  buffer_load_dwordx4 v[88:91], v1, s[16:19], s45 offen nt
  buffer_load_dwordx4 v[92:95], v1, s[16:19], s45 offen offset:1024 nt
  buffer_load_dwordx4 v[96:99], v1, s[16:19], s45 offen offset:2048 nt
  buffer_load_dwordx4 v[100:103], v1, s[16:19], s45 offen offset:3072 nt
  buffer_load_dwordx4 v[104:107], v1, s[16:19], s46 offen nt
  buffer_load_dwordx4 v[108:111], v1, s[16:19], s46 offen offset:1024 nt
  buffer_load_dwordx4 v[112:115], v1, s[16:19], s46 offen offset:2048 nt
  buffer_load_dwordx4 v[116:119], v1, s[20:23], 0 offen nt
  buffer_load_dwordx4 v[120:123], v1, s[20:23], 0 offen offset:1024 nt
  buffer_load_dwordx4 v[124:127], v1, s[20:23], 0 offen offset:2048 nt
  s_cmp_ge_u32 s3, 4
  s_cbranch_scc1 L_nb1
  s_barrier
L_nb1:
  v_and_b32 v3, 1, v0
  v_lshlrev_b32 v3, 4, v3
  v_mov_b32 v4, 0xffff
  v_lshlrev_b32 v4, v3, v4
  v_bfe_u32 v3, v0, 1, 2
  v_cmp_eq_u32 vcc, 0, v3
  s_nop 1
  v_cndmask_b32 v38, 0, v4, vcc
  v_cmp_eq_u32 vcc, 1, v3
  s_nop 1
  v_cndmask_b32 v39, 0, v4, vcc
  v_cmp_eq_u32 vcc, 2, v3
  s_nop 1
  v_cndmask_b32 v40, 0, v4, vcc
  v_cmp_eq_u32 vcc, 3, v3
  s_nop 1
  v_cndmask_b32 v41, 0, v4, vcc
  v_and_b32 v6, 8, v0
  s_lshl_b32 s53, s3, 4
  s_add_u32 s53, s53, 16384
  v_add_u32 v6, s53, v6
  v_lshrrev_b32 v7, 5, v0
  v_lshlrev_b32 v7, 3, v7
  s_lshl_b32 s53, s3, 10
  v_add_u32 v5, s53, v1
  s_mov_b32 s48, 0x3e0293ee
  s_mov_b32 s49, 0x3f80
  v_mov_b32 v54, 0x10000
  v_mov_b32 v55, 0x1000000
  s_cmp_lt_u32 s3, 12
  s_cselect_b32 s53, 0x100, 0
  v_mov_b32 v52, 1
  v_mov_b32 v53, s53
  s_waitcnt vmcnt(17)
  v_dot2_f32_bf16 v34, v56, v8, 0
  v_dot2_f32_bf16 v35, v56, v12, 0
  v_dot2_f32_bf16 v34, v57, v9, v34
  v_dot2_f32_bf16 v35, v57, v13, v35
  v_dot2_f32_bf16 v34, v58, v10, v34
  v_dot2_f32_bf16 v35, v58, v14, v35
  v_dot2_f32_bf16 v34, v59, v11, v34
  v_dot2_f32_bf16 v35, v59, v15, v35
  buffer_load_dwordx4 v[56:59], v1, s[20:23], 0 offen offset:3072 nt
  s_waitcnt vmcnt(17)
  v_dot2_f32_bf16 v36, v60, v8, 0
  v_dot2_f32_bf16 v37, v60, v12, 0
  v_add_f32_dpp v16, v34, v34 row_ror:8 row_mask:0xf bank_mask:0x3
  v_add_f32_dpp v16, v35, v35 row_ror:8 row_mask:0xf bank_mask:0xc
  v_dot2_f32_bf16 v36, v61, v9, v36
  v_dot2_f32_bf16 v37, v61, v13, v37
  v_add_f32_dpp v16, v16, v16 row_half_mirror row_mask:0xf bank_mask:0xf
  v_dot2_f32_bf16 v36, v62, v10, v36
  v_dot2_f32_bf16 v37, v62, v14, v37
  v_add_f32_dpp v16, v16, v16 quad_perm:[1,0,3,2] row_mask:0xf bank_mask:0xf
  v_dot2_f32_bf16 v36, v63, v11, v36
  v_dot2_f32_bf16 v37, v63, v15, v37
  v_add_f32_dpp v16, v16, v16 quad_perm:[2,3,0,1] row_mask:0xf bank_mask:0xf
  buffer_load_dwordx4 v[60:63], v1, s[20:23], s44 offen nt
  s_waitcnt vmcnt(17)
  v_dot2_f32_bf16 v34, v64, v8, 0
  v_dot2_f32_bf16 v35, v64, v12, 0
  v_add_f32_dpp v17, v36, v36 row_ror:8 row_mask:0xf bank_mask:0x3
  v_add_f32_dpp v17, v37, v37 row_ror:8 row_mask:0xf bank_mask:0xc
  v_dot2_f32_bf16 v34, v65, v9, v34
  v_dot2_f32_bf16 v35, v65, v13, v35
  v_add_f32_dpp v17, v17, v17 row_half_mirror row_mask:0xf bank_mask:0xf
  v_dot2_f32_bf16 v34, v66, v10, v34
  v_dot2_f32_bf16 v35, v66, v14, v35
  v_add_f32_dpp v17, v17, v17 quad_perm:[1,0,3,2] row_mask:0xf bank_mask:0xf
  v_dot2_f32_bf16 v34, v67, v11, v34
  v_dot2_f32_bf16 v35, v67, v15, v35
  v_add_f32_dpp v17, v17, v17 quad_perm:[2,3,0,1] row_mask:0xf bank_mask:0xf
  buffer_load_dwordx4 v[64:67], v1, s[20:23], s44 offen offset:1024 nt
  s_waitcnt vmcnt(17)
  v_dot2_f32_bf16 v36, v68, v8, 0
  v_dot2_f32_bf16 v37, v68, v12, 0
  v_add_f32_dpp v18, v34, v34 row_ror:8 row_mask:0xf bank_mask:0x3
  v_add_f32_dpp v18, v35, v35 row_ror:8 row_mask:0xf bank_mask:0xc
  v_dot2_f32_bf16 v36, v69, v9, v36
  v_dot2_f32_bf16 v37, v69, v13, v37
  v_add_f32_dpp v18, v18, v18 row_half_mirror row_mask:0xf bank_mask:0xf
  v_dot2_f32_bf16 v36, v70, v10, v36
  v_dot2_f32_bf16 v37, v70, v14, v37
  v_add_f32_dpp v18, v18, v18 quad_perm:[1,0,3,2] row_mask:0xf bank_mask:0xf
  v_dot2_f32_bf16 v36, v71, v11, v36
  v_dot2_f32_bf16 v37, v71, v15, v37
  v_add_f32_dpp v18, v18, v18 quad_perm:[2,3,0,1] row_mask:0xf bank_mask:0xf
  buffer_load_dwordx4 v[68:71], v1, s[20:23], s44 offen offset:2048 nt
  s_waitcnt vmcnt(17)
  v_dot2_f32_bf16 v34, v72, v8, 0
  v_dot2_f32_bf16 v35, v72, v12, 0
  v_add_f32_dpp v19, v36, v36 row_ror:8 row_mask:0xf bank_mask:0x3
  v_add_f32_dpp v19, v37, v37 row_ror:8 row_mask:0xf bank_mask:0xc
  v_dot2_f32_bf16 v34, v73, v9, v34
  v_dot2_f32_bf16 v35, v73, v13, v35
  v_add_f32_dpp v19, v19, v19 row_half_mirror row_mask:0xf bank_mask:0xf
  v_dot2_f32_bf16 v34, v74, v10, v34
  v_dot2_f32_bf16 v35, v74, v14, v35
  v_add_f32_dpp v19, v19, v19 quad_perm:[1,0,3,2] row_mask:0xf bank_mask:0xf
  v_dot2_f32_bf16 v34, v75, v11, v34
  v_dot2_f32_bf16 v35, v75, v15, v35
  v_add_f32_dpp v19, v19, v19 quad_perm:[2,3,0,1] row_mask:0xf bank_mask:0xf
  buffer_load_dwordx4 v[72:75], v1, s[20:23], s44 offen offset:3072 nt
  s_waitcnt vmcnt(17)
  v_dot2_f32_bf16 v36, v76, v8, 0
  v_dot2_f32_bf16 v37, v76, v12, 0
  v_add_f32_dpp v20, v34, v34 row_ror:8 row_mask:0xf bank_mask:0x3
  v_add_f32_dpp v20, v35, v35 row_ror:8 row_mask:0xf bank_mask:0xc
  v_dot2_f32_bf16 v36, v77, v9, v36
  v_dot2_f32_bf16 v37, v77, v13, v37
  v_add_f32_dpp v20, v20, v20 row_half_mirror row_mask:0xf bank_mask:0xf
  v_dot2_f32_bf16 v36, v78, v10, v36
  v_dot2_f32_bf16 v37, v78, v14, v37
  v_add_f32_dpp v20, v20, v20 quad_perm:[1,0,3,2] row_mask:0xf bank_mask:0xf
  v_dot2_f32_bf16 v36, v79, v11, v36
  v_dot2_f32_bf16 v37, v79, v15, v37
  v_add_f32_dpp v20, v20, v20 quad_perm:[2,3,0,1] row_mask:0xf bank_mask:0xf
  buffer_load_dwordx4 v[76:79], v1, s[20:23], s45 offen nt
  s_waitcnt vmcnt(17)
  v_dot2_f32_bf16 v34, v80, v8, 0
  v_dot2_f32_bf16 v35, v80, v12, 0
  v_add_f32_dpp v21, v36, v36 row_ror:8 row_mask:0xf bank_mask:0x3
  v_add_f32_dpp v21, v37, v37 row_ror:8 row_mask:0xf bank_mask:0xc
  v_dot2_f32_bf16 v34, v81, v9, v34
  v_dot2_f32_bf16 v35, v81, v13, v35
  v_add_f32_dpp v21, v21, v21 row_half_mirror row_mask:0xf bank_mask:0xf
  v_dot2_f32_bf16 v34, v82, v10, v34
  v_dot2_f32_bf16 v35, v82, v14, v35
  v_add_f32_dpp v21, v21, v21 quad_perm:[1,0,3,2] row_mask:0xf bank_mask:0xf
  v_dot2_f32_bf16 v34, v83, v11, v34
  v_dot2_f32_bf16 v35, v83, v15, v35
  v_add_f32_dpp v21, v21, v21 quad_perm:[2,3,0,1] row_mask:0xf bank_mask:0xf
  buffer_load_dwordx4 v[80:83], v1, s[20:23], s45 offen offset:1024 nt
  s_waitcnt vmcnt(17)
  v_dot2_f32_bf16 v36, v84, v8, 0
  v_dot2_f32_bf16 v37, v84, v12, 0
  v_add_f32_dpp v22, v34, v34 row_ror:8 row_mask:0xf bank_mask:0x3
  v_add_f32_dpp v22, v35, v35 row_ror:8 row_mask:0xf bank_mask:0xc
  v_dot2_f32_bf16 v36, v85, v9, v36
  v_dot2_f32_bf16 v37, v85, v13, v37
  v_add_f32_dpp v22, v22, v22 row_half_mirror row_mask:0xf bank_mask:0xf
  v_dot2_f32_bf16 v36, v86, v10, v36
  v_dot2_f32_bf16 v37, v86, v14, v37
  v_add_f32_dpp v22, v22, v22 quad_perm:[1,0,3,2] row_mask:0xf bank_mask:0xf
  v_dot2_f32_bf16 v36, v87, v11, v36
  v_dot2_f32_bf16 v37, v87, v15, v37
  v_add_f32_dpp v22, v22, v22 quad_perm:[2,3,0,1] row_mask:0xf bank_mask:0xf
  buffer_load_dwordx4 v[84:87], v1, s[20:23], s45 offen offset:2048 nt
  s_waitcnt vmcnt(17)
  v_dot2_f32_bf16 v34, v88, v8, 0
  v_dot2_f32_bf16 v35, v88, v12, 0
  v_add_f32_dpp v23, v36, v36 row_ror:8 row_mask:0xf bank_mask:0x3
  v_add_f32_dpp v23, v37, v37 row_ror:8 row_mask:0xf bank_mask:0xc
  v_dot2_f32_bf16 v34, v89, v9, v34
  v_dot2_f32_bf16 v35, v89, v13, v35
  v_add_f32_dpp v23, v23, v23 row_half_mirror row_mask:0xf bank_mask:0xf
  v_dot2_f32_bf16 v34, v90, v10, v34
  v_dot2_f32_bf16 v35, v90, v14, v35
  v_add_f32_dpp v23, v23, v23 quad_perm:[1,0,3,2] row_mask:0xf bank_mask:0xf
  v_dot2_f32_bf16 v34, v91, v11, v34
  v_dot2_f32_bf16 v35, v91, v15, v35
  v_add_f32_dpp v23, v23, v23 quad_perm:[2,3,0,1] row_mask:0xf bank_mask:0xf
  buffer_load_dwordx4 v[88:91], v1, s[20:23], s45 offen offset:3072 nt
  s_waitcnt vmcnt(17)
  v_dot2_f32_bf16 v36, v92, v8, 0
  v_dot2_f32_bf16 v37, v92, v12, 0
  v_add_f32_dpp v24, v34, v34 row_ror:8 row_mask:0xf bank_mask:0x3
  v_add_f32_dpp v24, v35, v35 row_ror:8 row_mask:0xf bank_mask:0xc
  v_dot2_f32_bf16 v36, v93, v9, v36
  v_dot2_f32_bf16 v37, v93, v13, v37
  v_add_f32_dpp v24, v24, v24 row_half_mirror row_mask:0xf bank_mask:0xf
  v_dot2_f32_bf16 v36, v94, v10, v36
  v_dot2_f32_bf16 v37, v94, v14, v37
  v_add_f32_dpp v24, v24, v24 quad_perm:[1,0,3,2] row_mask:0xf bank_mask:0xf
  v_dot2_f32_bf16 v36, v95, v11, v36
  v_dot2_f32_bf16 v37, v95, v15, v37
  v_add_f32_dpp v24, v24, v24 quad_perm:[2,3,0,1] row_mask:0xf bank_mask:0xf
  buffer_load_dwordx4 v[92:95], v1, s[20:23], s46 offen nt
  s_waitcnt vmcnt(17)
  v_dot2_f32_bf16 v34, v96, v8, 0
  v_dot2_f32_bf16 v35, v96, v12, 0
  v_add_f32_dpp v25, v36, v36 row_ror:8 row_mask:0xf bank_mask:0x3
  v_add_f32_dpp v25, v37, v37 row_ror:8 row_mask:0xf bank_mask:0xc
  v_dot2_f32_bf16 v34, v97, v9, v34
  v_dot2_f32_bf16 v35, v97, v13, v35
  v_add_f32_dpp v25, v25, v25 row_half_mirror row_mask:0xf bank_mask:0xf
  v_dot2_f32_bf16 v34, v98, v10, v34
  v_dot2_f32_bf16 v35, v98, v14, v35
  v_add_f32_dpp v25, v25, v25 quad_perm:[1,0,3,2] row_mask:0xf bank_mask:0xf
  v_dot2_f32_bf16 v34, v99, v11, v34
  v_dot2_f32_bf16 v35, v99, v15, v35
  v_add_f32_dpp v25, v25, v25 quad_perm:[2,3,0,1] row_mask:0xf bank_mask:0xf
  buffer_load_dwordx4 v[96:99], v1, s[20:23], s46 offen offset:1024 nt
  s_mov_b64 exec, 1
  ds_add_u32 v1, v55 offset:16644
  s_mov_b64 exec, -1
  s_waitcnt vmcnt(17)
  v_dot2_f32_bf16 v36, v100, v8, 0
  v_dot2_f32_bf16 v37, v100, v12, 0
  v_add_f32_dpp v26, v34, v34 row_ror:8 row_mask:0xf bank_mask:0x3
  v_add_f32_dpp v26, v35, v35 row_ror:8 row_mask:0xf bank_mask:0xc
  v_dot2_f32_bf16 v36, v101, v9, v36
  v_dot2_f32_bf16 v37, v101, v13, v37
  v_add_f32_dpp v26, v26, v26 row_half_mirror row_mask:0xf bank_mask:0xf
  v_dot2_f32_bf16 v36, v102, v10, v36
  v_dot2_f32_bf16 v37, v102, v14, v37
  v_add_f32_dpp v26, v26, v26 quad_perm:[1,0,3,2] row_mask:0xf bank_mask:0xf
  v_dot2_f32_bf16 v36, v103, v11, v36
  v_dot2_f32_bf16 v37, v103, v15, v37
  v_add_f32_dpp v26, v26, v26 quad_perm:[2,3,0,1] row_mask:0xf bank_mask:0xf
  buffer_load_dwordx4 v[100:103], v1, s[20:23], s46 offen offset:2048 nt
  s_waitcnt vmcnt(17)
  v_dot2_f32_bf16 v34, v104, v8, 0
  v_dot2_f32_bf16 v35, v104, v12, 0
  v_add_f32_dpp v27, v36, v36 row_ror:8 row_mask:0xf bank_mask:0x3
  v_add_f32_dpp v27, v37, v37 row_ror:8 row_mask:0xf bank_mask:0xc
  v_dot2_f32_bf16 v34, v105, v9, v34
  v_dot2_f32_bf16 v35, v105, v13, v35
  v_add_f32_dpp v27, v27, v27 row_half_mirror row_mask:0xf bank_mask:0xf
  v_dot2_f32_bf16 v34, v106, v10, v34
  v_dot2_f32_bf16 v35, v106, v14, v35
  v_add_f32_dpp v27, v27, v27 quad_perm:[1,0,3,2] row_mask:0xf bank_mask:0xf
  v_dot2_f32_bf16 v34, v107, v11, v34
  v_dot2_f32_bf16 v35, v107, v15, v35
  v_add_f32_dpp v27, v27, v27 quad_perm:[2,3,0,1] row_mask:0xf bank_mask:0xf
  s_waitcnt vmcnt(16)
  s_nop 0
  v_dot2_f32_bf16 v36, v108, v8, 0
  v_dot2_f32_bf16 v37, v108, v12, 0
  v_add_f32_dpp v28, v34, v34 row_ror:8 row_mask:0xf bank_mask:0x3
  v_add_f32_dpp v28, v35, v35 row_ror:8 row_mask:0xf bank_mask:0xc
  v_dot2_f32_bf16 v36, v109, v9, v36
  v_dot2_f32_bf16 v37, v109, v13, v37
  v_add_f32_dpp v28, v28, v28 row_half_mirror row_mask:0xf bank_mask:0xf
  v_dot2_f32_bf16 v36, v110, v10, v36
  v_dot2_f32_bf16 v37, v110, v14, v37
  v_add_f32_dpp v28, v28, v28 quad_perm:[1,0,3,2] row_mask:0xf bank_mask:0xf
  v_dot2_f32_bf16 v36, v111, v11, v36
  v_dot2_f32_bf16 v37, v111, v15, v37
  v_add_f32_dpp v28, v28, v28 quad_perm:[2,3,0,1] row_mask:0xf bank_mask:0xf
  s_waitcnt vmcnt(15)
  s_nop 0
  v_dot2_f32_bf16 v34, v112, v8, 0
  v_dot2_f32_bf16 v35, v112, v12, 0
  v_add_f32_dpp v29, v36, v36 row_ror:8 row_mask:0xf bank_mask:0x3
  v_add_f32_dpp v29, v37, v37 row_ror:8 row_mask:0xf bank_mask:0xc
  v_dot2_f32_bf16 v34, v113, v9, v34
  v_dot2_f32_bf16 v35, v113, v13, v35
  v_add_f32_dpp v29, v29, v29 row_half_mirror row_mask:0xf bank_mask:0xf
  v_dot2_f32_bf16 v34, v114, v10, v34
  v_dot2_f32_bf16 v35, v114, v14, v35
  v_add_f32_dpp v29, v29, v29 quad_perm:[1,0,3,2] row_mask:0xf bank_mask:0xf
  v_dot2_f32_bf16 v34, v115, v11, v34
  v_dot2_f32_bf16 v35, v115, v15, v35
  v_add_f32_dpp v29, v29, v29 quad_perm:[2,3,0,1] row_mask:0xf bank_mask:0xf
  s_nop 2
  v_add_f32_dpp v30, v34, v34 row_ror:8 row_mask:0xf bank_mask:0x3
  v_add_f32_dpp v30, v35, v35 row_ror:8 row_mask:0xf bank_mask:0xc
  s_nop 1
  v_add_f32_dpp v30, v30, v30 row_half_mirror row_mask:0xf bank_mask:0xf
  s_nop 1
  v_add_f32_dpp v30, v30, v30 quad_perm:[1,0,3,2] row_mask:0xf bank_mask:0xf
  s_nop 1
  v_add_f32_dpp v30, v30, v30 quad_perm:[2,3,0,1] row_mask:0xf bank_mask:0xf
  s_nop 1
  v_max3_f32 v49, v16, v17, v18
  v_max3_f32 v49, v49, v19, v20
  v_max3_f32 v49, v49, v21, v22
  v_max3_f32 v49, v49, v23, v24
  v_max3_f32 v49, v49, v25, v26
  v_max3_f32 v49, v49, v27, v28
  v_max3_f32 v49, v49, v29, v30
  v_mov_b32 v50, v49
  s_nop 1
  v_permlane16_swap_b32 v49, v50
  v_max_f32 v49, v49, v50
  v_mov_b32 v50, v49
  s_nop 1
  v_permlane32_swap_b32 v49, v50
  v_max_f32 v49, v49, v50
  v_mul_f32 v46, s48, v49
  v_fma_f32 v16, v16, s48, -v46
  v_fma_f32 v17, v17, s48, -v46
  v_fma_f32 v18, v18, s48, -v46
  v_fma_f32 v19, v19, s48, -v46
  v_fma_f32 v20, v20, s48, -v46
  v_fma_f32 v21, v21, s48, -v46
  v_fma_f32 v22, v22, s48, -v46
  v_fma_f32 v23, v23, s48, -v46
  v_fma_f32 v24, v24, s48, -v46
  v_fma_f32 v25, v25, s48, -v46
  v_fma_f32 v26, v26, s48, -v46
  v_fma_f32 v27, v27, s48, -v46
  v_fma_f32 v28, v28, s48, -v46
  v_fma_f32 v29, v29, s48, -v46
  v_fma_f32 v30, v30, s48, -v46
  v_exp_f32 v16, v16
  v_exp_f32 v17, v17
  v_exp_f32 v18, v18
  v_exp_f32 v19, v19
  v_exp_f32 v20, v20
  v_exp_f32 v21, v21
  v_exp_f32 v22, v22
  v_exp_f32 v23, v23
  v_exp_f32 v24, v24
  v_exp_f32 v25, v25
  v_exp_f32 v26, v26
  v_exp_f32 v27, v27
  v_exp_f32 v28, v28
  v_exp_f32 v29, v29
  v_exp_f32 v30, v30
  v_cvt_pk_bf16_f32 v16, v16, v16
  v_cvt_pk_bf16_f32 v17, v17, v17
  v_cvt_pk_bf16_f32 v18, v18, v18
  v_cvt_pk_bf16_f32 v19, v19, v19
  v_cvt_pk_bf16_f32 v20, v20, v20
  v_cvt_pk_bf16_f32 v21, v21, v21
  v_cvt_pk_bf16_f32 v22, v22, v22
  v_cvt_pk_bf16_f32 v23, v23, v23
  v_cvt_pk_bf16_f32 v24, v24, v24
  v_cvt_pk_bf16_f32 v25, v25, v25
  v_cvt_pk_bf16_f32 v26, v26, v26
  v_cvt_pk_bf16_f32 v27, v27, v27
  v_cvt_pk_bf16_f32 v28, v28, v28
  v_cvt_pk_bf16_f32 v29, v29, v29
  v_cvt_pk_bf16_f32 v30, v30, v30
  v_dot2_f32_bf16 v47, v16, s49, 0
  v_dot2_f32_bf16 v47, v17, s49, v47
  v_dot2_f32_bf16 v47, v18, s49, v47
  v_dot2_f32_bf16 v47, v19, s49, v47
  v_dot2_f32_bf16 v47, v20, s49, v47
  v_dot2_f32_bf16 v47, v21, s49, v47
  v_dot2_f32_bf16 v47, v22, s49, v47
  v_dot2_f32_bf16 v47, v23, s49, v47
  v_dot2_f32_bf16 v47, v24, s49, v47
  v_dot2_f32_bf16 v47, v25, s49, v47
  v_dot2_f32_bf16 v47, v26, s49, v47
  v_dot2_f32_bf16 v47, v27, s49, v47
  v_dot2_f32_bf16 v47, v28, s49, v47
  v_dot2_f32_bf16 v47, v29, s49, v47
  v_dot2_f32_bf16 v47, v30, s49, v47
  s_nop 2
  v_mov_b32 v50, v47
  s_nop 1
  v_permlane16_swap_b32 v47, v50
  v_add_f32 v47, v47, v50
  v_mov_b32 v50, v47
  s_nop 1
  v_permlane32_swap_b32 v47, v50
  v_add_f32 v47, v47, v50
  ds_write_b64 v6, v[46:47]
  s_mov_b64 exec, 1
  ds_add_u32 v1, v54 offset:16644
  s_mov_b64 exec, -1
  v_and_b32 v8, v16, v38
  v_and_b32 v9, v16, v39
  v_and_b32 v10, v16, v40
  v_and_b32 v11, v16, v41
  v_and_b32 v12, v17, v38
  v_and_b32 v13, v17, v39
  v_and_b32 v14, v17, v40
  v_and_b32 v15, v17, v41
  s_waitcnt vmcnt(14)
  v_mfma_f32_16x16x32_bf16 v[42:45], v[8:11], v[116:119], 0
  v_and_b32 v8, v18, v38
  v_and_b32 v9, v18, v39
  v_and_b32 v10, v18, v40
  v_and_b32 v11, v18, v41
  s_waitcnt vmcnt(13)
  v_mfma_f32_16x16x32_bf16 v[42:45], v[12:15], v[120:123], v[42:45]
  v_and_b32 v12, v19, v38
  v_and_b32 v13, v19, v39
  v_and_b32 v14, v19, v40
  v_and_b32 v15, v19, v41
  s_waitcnt vmcnt(12)
  v_mfma_f32_16x16x32_bf16 v[42:45], v[8:11], v[124:127], v[42:45]
  v_and_b32 v8, v20, v38
  v_and_b32 v9, v20, v39
  v_and_b32 v10, v20, v40
  v_and_b32 v11, v20, v41
  s_waitcnt vmcnt(11)
  v_mfma_f32_16x16x32_bf16 v[42:45], v[12:15], v[56:59], v[42:45]
  v_and_b32 v12, v21, v38
  v_and_b32 v13, v21, v39
  v_and_b32 v14, v21, v40
  v_and_b32 v15, v21, v41
  s_waitcnt vmcnt(10)
  v_mfma_f32_16x16x32_bf16 v[42:45], v[8:11], v[60:63], v[42:45]
  v_and_b32 v8, v22, v38
  v_and_b32 v9, v22, v39
  v_and_b32 v10, v22, v40
  v_and_b32 v11, v22, v41
  s_waitcnt vmcnt(9)
  v_mfma_f32_16x16x32_bf16 v[42:45], v[12:15], v[64:67], v[42:45]
  v_and_b32 v12, v23, v38
  v_and_b32 v13, v23, v39
  v_and_b32 v14, v23, v40
  v_and_b32 v15, v23, v41
  s_waitcnt vmcnt(8)
  v_mfma_f32_16x16x32_bf16 v[42:45], v[8:11], v[68:71], v[42:45]
  v_and_b32 v8, v24, v38
  v_and_b32 v9, v24, v39
  v_and_b32 v10, v24, v40
  v_and_b32 v11, v24, v41
  s_waitcnt vmcnt(7)
  v_mfma_f32_16x16x32_bf16 v[42:45], v[12:15], v[72:75], v[42:45]
  v_and_b32 v12, v25, v38
  v_and_b32 v13, v25, v39
  v_and_b32 v14, v25, v40
  v_and_b32 v15, v25, v41
  s_waitcnt vmcnt(6)
  v_mfma_f32_16x16x32_bf16 v[42:45], v[8:11], v[76:79], v[42:45]
  v_and_b32 v8, v26, v38
  v_and_b32 v9, v26, v39
  v_and_b32 v10, v26, v40
  v_and_b32 v11, v26, v41
  s_waitcnt vmcnt(5)
  s_mov_b64 exec, 1
  ds_add_u32 v1, v52 offset:16644
  s_mov_b64 exec, -1
  v_mfma_f32_16x16x32_bf16 v[42:45], v[12:15], v[80:83], v[42:45]
  v_and_b32 v12, v27, v38
  v_and_b32 v13, v27, v39
  v_and_b32 v14, v27, v40
  v_and_b32 v15, v27, v41
  s_waitcnt vmcnt(4)
  v_mfma_f32_16x16x32_bf16 v[42:45], v[8:11], v[84:87], v[42:45]
  v_and_b32 v8, v28, v38
  v_and_b32 v9, v28, v39
  v_and_b32 v10, v28, v40
  v_and_b32 v11, v28, v41
  s_waitcnt vmcnt(3)
  v_mfma_f32_16x16x32_bf16 v[42:45], v[12:15], v[88:91], v[42:45]
  v_and_b32 v12, v29, v38
  v_and_b32 v13, v29, v39
  v_and_b32 v14, v29, v40
  v_and_b32 v15, v29, v41
  s_waitcnt vmcnt(2)
  v_mfma_f32_16x16x32_bf16 v[42:45], v[8:11], v[92:95], v[42:45]
  v_and_b32 v8, v30, v38
  v_and_b32 v9, v30, v39
  v_and_b32 v10, v30, v40
  v_and_b32 v11, v30, v41
  s_waitcnt vmcnt(1)
  v_mfma_f32_16x16x32_bf16 v[42:45], v[12:15], v[96:99], v[42:45]
  s_nop 1
  s_waitcnt vmcnt(0)
  v_mfma_f32_16x16x32_bf16 v[42:45], v[8:11], v[100:103], v[42:45]
L_join:
  s_cmp_lg_u32 s3, 0
  s_nop 7
  ds_write_b128 v5, v[42:45]
  s_cbranch_scc1 L_worker
  s_lshl_b32 s50, s42, 13
  s_add_u32 s28, s14, s50
  s_addc_u32 s29, s15, 0
  s_movk_i32 s30, 8192
  s_mov_b32 s31, 0x20000
  s_add_u32 s32, s10, s43
  s_addc_u32 s33, s11, 0
  s_movk_i32 s34, 0x200
  s_mov_b32 s35, 0x20000
  s_mov_b32 s36, s12
  s_mov_b32 s37, s13
  s_movk_i32 s38, 0x100
  s_mov_b32 s39, 0x20000
  s_and_b32 s51, s2, 3
  s_lshl_b32 s51, s51, 11
  s_lshl_b32 s52, s42, 2
  v_lshlrev_b32 v3, 3, v0
  v_lshrrev_b32 v4, 5, v0
  v_lshlrev_b32 v4, 8, v4
  v_and_b32 v2, 15, v0
  v_lshl_add_u32 v4, v2, 4, v4
  v_bfe_u32 v2, v0, 4, 1
  v_lshl_add_u32 v4, v2, 3, v4
  v_mov_b32 v2, 1
  s_xor_b32 s56, s51, 2048
  s_xor_b32 s57, s51, 4096
  s_xor_b32 s58, s51, 6144
  v_mov_b32 v6, 16640
  v_and_b32 v8, 15, v0
  v_lshl_add_u32 v7, v8, 4, v7
  v_cmp_gt_u32 s[60:61], 12, v8
  v_cmp_eq_u32 s[62:63], 0, v8
  v_mov_b32 v14, 0xff7fffff
  buffer_load_dwordx4 v[56:59], v1, s[28:31], s51 offen nt
  v_and_b32 v15, 31, v0
  v_cmp_gt_u32 s[26:27], 32, v0
  s_lshr_b32 s16, s51, 8
  s_waitcnt vmcnt(0)
  v_and_b32 v16, 3, v56
  v_and_b32 v17, 3, v57
  v_lshl_or_b32 v16, v17, 2, v16
  v_and_b32 v17, 3, v58
  v_lshl_or_b32 v16, v17, 4, v16
  v_and_b32 v17, 1, v59
  v_lshl_or_b32 v16, v17, 6, v16
  s_nop 0
  v_readfirstlane_b32 s59, v16
  s_nop 2
  s_not_b32 s59, s59
L_tag:
  s_and_b32 s59, s59, 0x7f
  v_cmp_eq_u32 vcc, s59, v16
  s_add_u32 s59, s59, 1
  s_cbranch_vccnz L_tag
  s_sub_u32 s59, s59, 1
  s_or_b32 s17, s59, 0x80
  s_lshl_b32 s17, s17, s16
  v_mov_b32 v2, s17
  s_lshl_b32 s18, 0xff, s16
  s_andn2_b32 s24, 0x80808080, s18
  s_or_b32 s18, s18, 0x80808080
  s_mov_b32 s25, 0x40000
  s_and_b32 s20, s59, 3
  s_bfe_u32 s21, s59, 0x20002
  s_bfe_u32 s22, s59, 0x20004
  s_lshr_b32 s23, s59, 6
L_p1:
  ds_read_b32 v5, v6 offset:4
  s_waitcnt lgkmcnt(0)
  v_readfirstlane_b32 s54, v5
  s_nop 1
  s_bfe_u32 s54, s54, 0x80008
  s_cmp_lt_u32 s54, 11
  s_cbranch_scc1 L_p1
  ds_read_b64 v[8:9], v7 offset:16384
  ds_read_b128 v[64:67], v1 offset:0
  ds_read_b128 v[68:71], v1 offset:1024
  ds_read_b128 v[72:75], v1 offset:2048
  ds_read_b128 v[76:79], v1 offset:3072
  ds_read_b128 v[80:83], v1 offset:4096
  ds_read_b128 v[84:87], v1 offset:5120
  ds_read_b128 v[88:91], v1 offset:6144
  ds_read_b128 v[92:95], v1 offset:7168
  ds_read_b128 v[96:99], v1 offset:8192
  ds_read_b128 v[100:103], v1 offset:9216
  ds_read_b128 v[104:107], v1 offset:10240
  ds_read_b128 v[108:111], v1 offset:11264
  s_waitcnt lgkmcnt(12)
  v_cndmask_b32 v8, v14, v8, s[60:61]
  v_cndmask_b32 v9, 0, v9, s[60:61]
  s_nop 0
  v_max_f32_dpp v10, v8, v8 row_ror:8 row_mask:0xf bank_mask:0xf
  s_nop 1
  v_max_f32_dpp v10, v10, v10 row_ror:4 row_mask:0xf bank_mask:0xf
  s_nop 1
  v_max_f32_dpp v10, v10, v10 row_ror:2 row_mask:0xf bank_mask:0xf
  s_nop 1
  v_max_f32_dpp v10, v10, v10 row_ror:1 row_mask:0xf bank_mask:0xf
  v_sub_f32 v12, v8, v10
  v_exp_f32 v12, v12
  s_nop 0
  v_mul_f32 v9, v9, v12
  s_nop 1
  v_add_f32_dpp v13, v9, v9 row_ror:8 row_mask:0xf bank_mask:0xf
  s_nop 1
  v_add_f32_dpp v13, v13, v13 row_ror:4 row_mask:0xf bank_mask:0xf
  s_nop 1
  v_add_f32_dpp v13, v13, v13 row_ror:2 row_mask:0xf bank_mask:0xf
  s_nop 1
  v_add_f32_dpp v13, v13, v13 row_ror:1 row_mask:0xf bank_mask:0xf
  s_waitcnt lgkmcnt(11)
  v_mul_f32_dpp v42, v12, v64 row_newbcast:0 row_mask:0xf bank_mask:0xf
  v_mul_f32_dpp v43, v12, v65 row_newbcast:0 row_mask:0xf bank_mask:0xf
  v_mul_f32_dpp v44, v12, v66 row_newbcast:0 row_mask:0xf bank_mask:0xf
  v_mul_f32_dpp v45, v12, v67 row_newbcast:0 row_mask:0xf bank_mask:0xf
  s_waitcnt lgkmcnt(10)
  v_fmac_f32_dpp v42, v12, v68 row_newbcast:1 row_mask:0xf bank_mask:0xf
  v_fmac_f32_dpp v43, v12, v69 row_newbcast:1 row_mask:0xf bank_mask:0xf
  v_fmac_f32_dpp v44, v12, v70 row_newbcast:1 row_mask:0xf bank_mask:0xf
  v_fmac_f32_dpp v45, v12, v71 row_newbcast:1 row_mask:0xf bank_mask:0xf
  s_waitcnt lgkmcnt(9)
  v_fmac_f32_dpp v42, v12, v72 row_newbcast:2 row_mask:0xf bank_mask:0xf
  v_fmac_f32_dpp v43, v12, v73 row_newbcast:2 row_mask:0xf bank_mask:0xf
  v_fmac_f32_dpp v44, v12, v74 row_newbcast:2 row_mask:0xf bank_mask:0xf
  v_fmac_f32_dpp v45, v12, v75 row_newbcast:2 row_mask:0xf bank_mask:0xf
  s_waitcnt lgkmcnt(8)
  v_fmac_f32_dpp v42, v12, v76 row_newbcast:3 row_mask:0xf bank_mask:0xf
  v_fmac_f32_dpp v43, v12, v77 row_newbcast:3 row_mask:0xf bank_mask:0xf
  v_fmac_f32_dpp v44, v12, v78 row_newbcast:3 row_mask:0xf bank_mask:0xf
  v_fmac_f32_dpp v45, v12, v79 row_newbcast:3 row_mask:0xf bank_mask:0xf
  s_waitcnt lgkmcnt(7)
  v_fmac_f32_dpp v42, v12, v80 row_newbcast:4 row_mask:0xf bank_mask:0xf
  v_fmac_f32_dpp v43, v12, v81 row_newbcast:4 row_mask:0xf bank_mask:0xf
  v_fmac_f32_dpp v44, v12, v82 row_newbcast:4 row_mask:0xf bank_mask:0xf
  v_fmac_f32_dpp v45, v12, v83 row_newbcast:4 row_mask:0xf bank_mask:0xf
  s_waitcnt lgkmcnt(6)
  v_fmac_f32_dpp v42, v12, v84 row_newbcast:5 row_mask:0xf bank_mask:0xf
  v_fmac_f32_dpp v43, v12, v85 row_newbcast:5 row_mask:0xf bank_mask:0xf
  v_fmac_f32_dpp v44, v12, v86 row_newbcast:5 row_mask:0xf bank_mask:0xf
  v_fmac_f32_dpp v45, v12, v87 row_newbcast:5 row_mask:0xf bank_mask:0xf
  s_waitcnt lgkmcnt(5)
  v_fmac_f32_dpp v42, v12, v88 row_newbcast:6 row_mask:0xf bank_mask:0xf
  v_fmac_f32_dpp v43, v12, v89 row_newbcast:6 row_mask:0xf bank_mask:0xf
  v_fmac_f32_dpp v44, v12, v90 row_newbcast:6 row_mask:0xf bank_mask:0xf
  v_fmac_f32_dpp v45, v12, v91 row_newbcast:6 row_mask:0xf bank_mask:0xf
  s_waitcnt lgkmcnt(4)
  v_fmac_f32_dpp v42, v12, v92 row_newbcast:7 row_mask:0xf bank_mask:0xf
  v_fmac_f32_dpp v43, v12, v93 row_newbcast:7 row_mask:0xf bank_mask:0xf
  v_fmac_f32_dpp v44, v12, v94 row_newbcast:7 row_mask:0xf bank_mask:0xf
  v_fmac_f32_dpp v45, v12, v95 row_newbcast:7 row_mask:0xf bank_mask:0xf
  s_waitcnt lgkmcnt(3)
  v_fmac_f32_dpp v42, v12, v96 row_newbcast:8 row_mask:0xf bank_mask:0xf
  v_fmac_f32_dpp v43, v12, v97 row_newbcast:8 row_mask:0xf bank_mask:0xf
  v_fmac_f32_dpp v44, v12, v98 row_newbcast:8 row_mask:0xf bank_mask:0xf
  v_fmac_f32_dpp v45, v12, v99 row_newbcast:8 row_mask:0xf bank_mask:0xf
  s_waitcnt lgkmcnt(2)
  v_fmac_f32_dpp v42, v12, v100 row_newbcast:9 row_mask:0xf bank_mask:0xf
  v_fmac_f32_dpp v43, v12, v101 row_newbcast:9 row_mask:0xf bank_mask:0xf
  v_fmac_f32_dpp v44, v12, v102 row_newbcast:9 row_mask:0xf bank_mask:0xf
  v_fmac_f32_dpp v45, v12, v103 row_newbcast:9 row_mask:0xf bank_mask:0xf
  s_waitcnt lgkmcnt(1)
  v_fmac_f32_dpp v42, v12, v104 row_newbcast:10 row_mask:0xf bank_mask:0xf
  v_fmac_f32_dpp v43, v12, v105 row_newbcast:10 row_mask:0xf bank_mask:0xf
  v_fmac_f32_dpp v44, v12, v106 row_newbcast:10 row_mask:0xf bank_mask:0xf
  v_fmac_f32_dpp v45, v12, v107 row_newbcast:10 row_mask:0xf bank_mask:0xf
  s_waitcnt lgkmcnt(0)
  v_fmac_f32_dpp v42, v12, v108 row_newbcast:11 row_mask:0xf bank_mask:0xf
  v_fmac_f32_dpp v43, v12, v109 row_newbcast:11 row_mask:0xf bank_mask:0xf
  v_fmac_f32_dpp v44, v12, v110 row_newbcast:11 row_mask:0xf bank_mask:0xf
  v_fmac_f32_dpp v45, v12, v111 row_newbcast:11 row_mask:0xf bank_mask:0xf
  v_cndmask_b32 v13, 0, v13, s[62:63]
L_p3:
  ds_read_b32 v5, v6 offset:4
  s_waitcnt lgkmcnt(0)
  v_readfirstlane_b32 s54, v5
  s_nop 1
  s_bfe_u32 s54, s54, 0x80018
  s_cmp_lt_u32 s54, 16
  s_cbranch_scc1 L_p3
  s_mov_b64 exec, 1
  buffer_atomic_add v2, off, s[36:39], s52 sc0
  s_mov_b64 exec, -1
L_p3b:
  ds_read_b32 v5, v6 offset:4
  s_waitcnt lgkmcnt(0)
  v_readfirstlane_b32 s54, v5
  s_nop 1
  s_bfe_u32 s54, s54, 0x80010
  s_cmp_lt_u32 s54, 16
  s_cbranch_scc1 L_p3b
  ds_read_b64 v[8:9], v7 offset:16384
  s_waitcnt lgkmcnt(0)
  v_cndmask_b32 v8, v8, v10, s[60:61]
  v_cndmask_b32 v9, v9, v13, s[60:61]
  s_nop 0
  v_max_f32_dpp v52, v8, v8 row_ror:8 row_mask:0xf bank_mask:0xf
  s_nop 1
  v_max_f32_dpp v52, v52, v52 row_ror:4 row_mask:0xf bank_mask:0xf
  s_nop 1
  v_max_f32_dpp v52, v52, v52 row_ror:2 row_mask:0xf bank_mask:0xf
  s_nop 1
  v_max_f32_dpp v52, v52, v52 row_ror:1 row_mask:0xf bank_mask:0xf
  v_sub_f32 v12, v8, v52
  v_exp_f32 v12, v12
  s_nop 0
  v_mul_f32 v9, v9, v12
  s_nop 1
  v_add_f32_dpp v53, v9, v9 row_ror:8 row_mask:0xf bank_mask:0xf
  s_nop 1
  v_add_f32_dpp v53, v53, v53 row_ror:4 row_mask:0xf bank_mask:0xf
  s_nop 1
  v_add_f32_dpp v53, v53, v53 row_ror:2 row_mask:0xf bank_mask:0xf
  s_nop 1
  v_add_f32_dpp v53, v53, v53 row_ror:1 row_mask:0xf bank_mask:0xf
  s_nop 1
  v_mov_b32_dpp v53, v53 row_newbcast:0 row_mask:0xf bank_mask:0xf
  v_rcp_f32 v11, v53
  v_log_f32 v53, v53
  s_nop 0
  v_mul_f32 v12, v12, v11
  v_add_f32 v52, v52, v53
  s_nop 0
  v_mul_f32_dpp v42, v12, v42 row_newbcast:0 row_mask:0xf bank_mask:0xf
  v_mul_f32_dpp v43, v12, v43 row_newbcast:0 row_mask:0xf bank_mask:0xf
  v_mul_f32_dpp v44, v12, v44 row_newbcast:0 row_mask:0xf bank_mask:0xf
  v_mul_f32_dpp v45, v12, v45 row_newbcast:0 row_mask:0xf bank_mask:0xf
  v_bfe_u32 v17, v52, v15, 1
  v_lshl_or_b32 v17, v17, 1, s23
L_p2:
  ds_read_b32 v5, v6 offset:4
  s_waitcnt lgkmcnt(0)
  v_readfirstlane_b32 s54, v5
  s_nop 1
  s_bfe_u32 s54, s54, 0x80000
  s_cmp_lt_u32 s54, 16
  s_cbranch_scc1 L_p2
  buffer_load_dwordx4 v[56:59], v1, s[28:31], s56 offen sc1
  buffer_load_dwordx4 v[60:63], v1, s[28:31], s57 offen sc1
  buffer_load_dwordx4 v[48:51], v1, s[28:31], s58 offen sc1
  s_barrier
  ds_read_b128 v[96:99], v1 offset:12288
  ds_read_b128 v[100:103], v1 offset:13312
  ds_read_b128 v[104:107], v1 offset:14336
  ds_read_b128 v[108:111], v1 offset:15360
  s_waitcnt vmcnt(3)
  v_readfirstlane_b32 s55, v2
  s_nop 2
  s_and_b32 s54, s55, s18
  s_cmp_eq_u32 s54, s24
  s_cselect_b32 s19, 1, 0
  s_cbranch_scc0 L_nl
  buffer_load_dwordx4 v[64:67], v1, s[28:31], s56 offen sc1
  buffer_load_dwordx4 v[68:71], v1, s[28:31], s57 offen sc1
  buffer_load_dwordx4 v[72:75], v1, s[28:31], s58 offen sc1
  s_lshr_b32 s54, s56, 8
  s_lshr_b32 s54, s55, s54
  s_and_b32 s44, s54, 0x7f
  s_lshr_b32 s54, s57, 8
  s_lshr_b32 s54, s55, s54
  s_and_b32 s45, s54, 0x7f
  s_lshr_b32 s54, s58, 8
  s_lshr_b32 s54, s55, s54
  s_and_b32 s46, s54, 0x7f
L_nl:
  s_waitcnt lgkmcnt(3)
  v_fmac_f32_dpp v42, v12, v96 row_newbcast:12 row_mask:0xf bank_mask:0xf
  v_fmac_f32_dpp v43, v12, v97 row_newbcast:12 row_mask:0xf bank_mask:0xf
  v_fmac_f32_dpp v44, v12, v98 row_newbcast:12 row_mask:0xf bank_mask:0xf
  v_fmac_f32_dpp v45, v12, v99 row_newbcast:12 row_mask:0xf bank_mask:0xf
  s_waitcnt lgkmcnt(2)
  v_fmac_f32_dpp v42, v12, v100 row_newbcast:13 row_mask:0xf bank_mask:0xf
  v_fmac_f32_dpp v43, v12, v101 row_newbcast:13 row_mask:0xf bank_mask:0xf
  v_fmac_f32_dpp v44, v12, v102 row_newbcast:13 row_mask:0xf bank_mask:0xf
  v_fmac_f32_dpp v45, v12, v103 row_newbcast:13 row_mask:0xf bank_mask:0xf
  s_waitcnt lgkmcnt(1)
  v_fmac_f32_dpp v42, v12, v104 row_newbcast:14 row_mask:0xf bank_mask:0xf
  v_fmac_f32_dpp v43, v12, v105 row_newbcast:14 row_mask:0xf bank_mask:0xf
  v_fmac_f32_dpp v44, v12, v106 row_newbcast:14 row_mask:0xf bank_mask:0xf
  v_fmac_f32_dpp v45, v12, v107 row_newbcast:14 row_mask:0xf bank_mask:0xf
  s_waitcnt lgkmcnt(0)
  v_fmac_f32_dpp v42, v12, v108 row_newbcast:15 row_mask:0xf bank_mask:0xf
  v_fmac_f32_dpp v43, v12, v109 row_newbcast:15 row_mask:0xf bank_mask:0xf
  v_fmac_f32_dpp v44, v12, v110 row_newbcast:15 row_mask:0xf bank_mask:0xf
  v_fmac_f32_dpp v45, v12, v111 row_newbcast:15 row_mask:0xf bank_mask:0xf
  s_cmp_lg_u32 s19, 0
  v_and_b32 v42, -4, v42
  v_and_b32 v43, -4, v43
  v_and_b32 v44, -4, v44
  v_and_b32 v45, -4, v45
  s_cbranch_scc1 L_last
  v_or_b32 v42, s20, v42
  v_or_b32 v43, s21, v43
  v_or_b32 v44, s22, v44
  v_or_b32 v45, v17, v45
  buffer_store_dwordx4 v[42:45], v1, s[28:31], s51 offen sc1
  s_endpgm
L_againB:
  s_sub_u32 s25, s25, 1
  s_cbranch_scc1 L_end
  buffer_load_dwordx4 v[64:67], v1, s[28:31], s56 offen sc1
  buffer_load_dwordx4 v[68:71], v1, s[28:31], s57 offen sc1
  buffer_load_dwordx4 v[72:75], v1, s[28:31], s58 offen sc1
L_last:
  s_waitcnt vmcnt(3)
  v_and_b32 v19, 3, v56
  v_and_b32 v18, 3, v57
  v_lshl_or_b32 v19, v18, 2, v19
  v_and_b32 v18, 3, v58
  v_lshl_or_b32 v19, v18, 4, v19
  v_and_b32 v18, 1, v59
  v_lshl_or_b32 v19, v18, 6, v19
  v_xor_b32 v19, s44, v19
  v_and_b32 v20, 3, v60
  v_and_b32 v18, 3, v61
  v_lshl_or_b32 v20, v18, 2, v20
  v_and_b32 v18, 3, v62
  v_lshl_or_b32 v20, v18, 4, v20
  v_and_b32 v18, 1, v63
  v_lshl_or_b32 v20, v18, 6, v20
  v_xor_b32 v20, s45, v20
  v_and_b32 v21, 3, v48
  v_and_b32 v18, 3, v49
  v_lshl_or_b32 v21, v18, 2, v21
  v_and_b32 v18, 3, v50
  v_lshl_or_b32 v21, v18, 4, v21
  v_and_b32 v18, 1, v51
  v_lshl_or_b32 v21, v18, 6, v21
  v_xor_b32 v21, s46, v21
  v_or3_b32 v19, v19, v20, v21
  v_cmp_ne_u32 vcc, 0, v19
  s_cbranch_vccnz L_againA
  v_and_b32 v19, 2, v59
  v_cmp_ne_u32 s[4:5], 0, v19
  v_and_b32 v20, 2, v63
  v_cmp_ne_u32 s[6:7], 0, v20
  v_and_b32 v21, 2, v51
  v_cmp_ne_u32 s[8:9], 0, v21
  v_and_b32 v56, -4, v56
  v_and_b32 v57, -4, v57
  v_and_b32 v58, -4, v58
  v_and_b32 v59, -4, v59
  v_mov_b32 v20, s5
  v_mov_b32 v18, s4
  v_cndmask_b32 v20, v20, v18, s[26:27]
  v_mov_b32 v22, s7
  v_mov_b32 v18, s6
  v_cndmask_b32 v22, v22, v18, s[26:27]
  v_mov_b32 v24, s9
  v_mov_b32 v18, s8
  v_cndmask_b32 v24, v24, v18, s[26:27]
  v_max3_f32 v10, v52, v20, v22
  v_max_f32 v10, v10, v24
  v_sub_f32 v18, v52, v10
  v_sub_f32 v20, v20, v10
  v_sub_f32 v22, v22, v10
  v_sub_f32 v24, v24, v10
  v_exp_f32 v18, v18
  v_exp_f32 v20, v20
  v_exp_f32 v22, v22
  v_exp_f32 v24, v24
  v_and_b32 v60, -4, v60
  v_and_b32 v61, -4, v61
  v_and_b32 v62, -4, v62
  v_and_b32 v63, -4, v63
  v_add_f32 v10, v18, v20
  v_add_f32 v11, v22, v24
  v_add_f32 v10, v10, v11
  v_rcp_f32 v10, v10
  v_and_b32 v48, -4, v48
  v_and_b32 v49, -4, v49
  v_and_b32 v50, -4, v50
  v_and_b32 v51, -4, v51
  v_pk_mul_f32 v[42:43], v[42:43], v[18:19] op_sel_hi:[1,0]
  v_pk_mul_f32 v[44:45], v[44:45], v[18:19] op_sel_hi:[1,0]
  v_pk_mul_f32 v[56:57], v[56:57], v[20:21] op_sel_hi:[1,0]
  v_pk_mul_f32 v[58:59], v[58:59], v[20:21] op_sel_hi:[1,0]
  v_pk_mul_f32 v[60:61], v[60:61], v[22:23] op_sel_hi:[1,0]
  v_pk_mul_f32 v[62:63], v[62:63], v[22:23] op_sel_hi:[1,0]
  v_pk_mul_f32 v[48:49], v[48:49], v[24:25] op_sel_hi:[1,0]
  v_pk_mul_f32 v[50:51], v[50:51], v[24:25] op_sel_hi:[1,0]
  v_pk_add_f32 v[42:43], v[42:43], v[56:57]
  v_pk_add_f32 v[44:45], v[44:45], v[58:59]
  v_pk_add_f32 v[60:61], v[60:61], v[48:49]
  v_pk_add_f32 v[62:63], v[62:63], v[50:51]
  v_pk_add_f32 v[42:43], v[42:43], v[60:61]
  v_pk_add_f32 v[44:45], v[44:45], v[62:63]
  v_pk_mul_f32 v[42:43], v[42:43], v[10:11] op_sel_hi:[1,0]
  v_pk_mul_f32 v[44:45], v[44:45], v[10:11] op_sel_hi:[1,0]
  v_cvt_pk_bf16_f32 v42, v42, v43
  v_cvt_pk_bf16_f32 v43, v44, v45
  buffer_store_dwordx2 v[42:43], v4, s[32:35], 0 offen
  s_endpgm
L_againA:
  buffer_load_dwordx4 v[56:59], v1, s[28:31], s56 offen sc1
  buffer_load_dwordx4 v[60:63], v1, s[28:31], s57 offen sc1
  buffer_load_dwordx4 v[48:51], v1, s[28:31], s58 offen sc1
  s_waitcnt vmcnt(3)
  v_and_b32 v19, 3, v64
  v_and_b32 v18, 3, v65
  v_lshl_or_b32 v19, v18, 2, v19
  v_and_b32 v18, 3, v66
  v_lshl_or_b32 v19, v18, 4, v19
  v_and_b32 v18, 1, v67
  v_lshl_or_b32 v19, v18, 6, v19
  v_xor_b32 v19, s44, v19
  v_and_b32 v20, 3, v68
  v_and_b32 v18, 3, v69
  v_lshl_or_b32 v20, v18, 2, v20
  v_and_b32 v18, 3, v70
  v_lshl_or_b32 v20, v18, 4, v20
  v_and_b32 v18, 1, v71
  v_lshl_or_b32 v20, v18, 6, v20
  v_xor_b32 v20, s45, v20
  v_and_b32 v21, 3, v72
  v_and_b32 v18, 3, v73
  v_lshl_or_b32 v21, v18, 2, v21
  v_and_b32 v18, 3, v74
  v_lshl_or_b32 v21, v18, 4, v21
  v_and_b32 v18, 1, v75
  v_lshl_or_b32 v21, v18, 6, v21
  v_xor_b32 v21, s46, v21
  v_or3_b32 v19, v19, v20, v21
  v_cmp_ne_u32 vcc, 0, v19
  s_cbranch_vccnz L_againB
  v_and_b32 v19, 2, v67
  v_cmp_ne_u32 s[4:5], 0, v19
  v_and_b32 v20, 2, v71
  v_cmp_ne_u32 s[6:7], 0, v20
  v_and_b32 v21, 2, v75
  v_cmp_ne_u32 s[8:9], 0, v21
  v_and_b32 v64, -4, v64
  v_and_b32 v65, -4, v65
  v_and_b32 v66, -4, v66
  v_and_b32 v67, -4, v67
  v_mov_b32 v20, s5
  v_mov_b32 v18, s4
  v_cndmask_b32 v20, v20, v18, s[26:27]
  v_mov_b32 v22, s7
  v_mov_b32 v18, s6
  v_cndmask_b32 v22, v22, v18, s[26:27]
  v_mov_b32 v24, s9
  v_mov_b32 v18, s8
  v_cndmask_b32 v24, v24, v18, s[26:27]
  v_max3_f32 v10, v52, v20, v22
  v_max_f32 v10, v10, v24
  v_sub_f32 v18, v52, v10
  v_sub_f32 v20, v20, v10
  v_sub_f32 v22, v22, v10
  v_sub_f32 v24, v24, v10
  v_exp_f32 v18, v18
  v_exp_f32 v20, v20
  v_exp_f32 v22, v22
  v_exp_f32 v24, v24
  v_and_b32 v68, -4, v68
  v_and_b32 v69, -4, v69
  v_and_b32 v70, -4, v70
  v_and_b32 v71, -4, v71
  v_add_f32 v10, v18, v20
  v_add_f32 v11, v22, v24
  v_add_f32 v10, v10, v11
  v_rcp_f32 v10, v10
  v_and_b32 v72, -4, v72
  v_and_b32 v73, -4, v73
  v_and_b32 v74, -4, v74
  v_and_b32 v75, -4, v75
  v_pk_mul_f32 v[42:43], v[42:43], v[18:19] op_sel_hi:[1,0]
  v_pk_mul_f32 v[44:45], v[44:45], v[18:19] op_sel_hi:[1,0]
  v_pk_mul_f32 v[64:65], v[64:65], v[20:21] op_sel_hi:[1,0]
  v_pk_mul_f32 v[66:67], v[66:67], v[20:21] op_sel_hi:[1,0]
  v_pk_mul_f32 v[68:69], v[68:69], v[22:23] op_sel_hi:[1,0]
  v_pk_mul_f32 v[70:71], v[70:71], v[22:23] op_sel_hi:[1,0]
  v_pk_mul_f32 v[72:73], v[72:73], v[24:25] op_sel_hi:[1,0]
  v_pk_mul_f32 v[74:75], v[74:75], v[24:25] op_sel_hi:[1,0]
  v_pk_add_f32 v[42:43], v[42:43], v[64:65]
  v_pk_add_f32 v[44:45], v[44:45], v[66:67]
  v_pk_add_f32 v[68:69], v[68:69], v[72:73]
  v_pk_add_f32 v[70:71], v[70:71], v[74:75]
  v_pk_add_f32 v[42:43], v[42:43], v[68:69]
  v_pk_add_f32 v[44:45], v[44:45], v[70:71]
  v_pk_mul_f32 v[42:43], v[42:43], v[10:11] op_sel_hi:[1,0]
  v_pk_mul_f32 v[44:45], v[44:45], v[10:11] op_sel_hi:[1,0]
  v_cvt_pk_bf16_f32 v42, v42, v43
  v_cvt_pk_bf16_f32 v43, v44, v45
  buffer_store_dwordx2 v[42:43], v4, s[32:35], 0 offen
  s_endpgm
L_worker:
  s_mov_b64 exec, 1
  ds_add_u32 v1, v53 offset:16644
  s_waitcnt lgkmcnt(0)
  s_barrier
L_end:
L_exit:
  s_endpgm
.section .rodata,"a"
.p2align 6
.amdhsa_kernel standalone__gqa_softmax__decode_kernel
  .amdhsa_next_free_vgpr 128
  .amdhsa_next_free_sgpr 64
  .amdhsa_accum_offset 128
  .amdhsa_group_segment_fixed_size 0
  .amdhsa_kernarg_size 48
  .amdhsa_user_sgpr_count 2
  .amdhsa_user_sgpr_kernarg_segment_ptr 1
  .amdhsa_system_sgpr_workgroup_id_x 1
.end_amdhsa_kernel
```
